```python
import torch

def _softmax(x, axis=-1):
    return torch.softmax(x, dim=axis)
def _gelu(x):
    return torch.nn.functional.gelu(x, approximate="tanh")
def _silu(x):
    return torch.nn.functional.silu(x)
def _sigmoid(x):
    return torch.sigmoid(x)
def _layernorm(x, axis=-1, eps=1e-5):
    m = x.mean(dim=axis, keepdim=True)
    v = x.var(dim=axis, keepdim=True, unbiased=False)
    return (x - m) / torch.sqrt(v + eps)
def _scatter_add(tgt, idx, src, axis=0):
    return tgt.clone().index_add_(axis, idx, src)
def _segment_sum(src, seg, n):
    out = torch.zeros((n,) + src.shape[1:], dtype=src.dtype)
    return out.index_add_(0, seg, src)
def _pad(x, pw):
    flat = tuple(v for pair in reversed(pw) for v in pair)
    return torch.nn.functional.pad(x, flat)

kernel_name = 'sequential_preLN__sliding_block_cached__dense_activation_gelu__decode'

def setup_inputs():

    _w = (lambda a: (lambda t: t.to(torch.bfloat16) if t.is_floating_point() else t)(torch.as_tensor(a)))
    def _A_setup():
        B, Sq, D = 2, 1, 512
        Hq, Hkv, Sk, Dh = 32, 8, 8192, 128
        assert Hq % Hkv == 0, (Hq, Hkv)
        return {
            "x": _w((lambda *s: torch.randn(*s, dtype=torch.bfloat16) * 0.05)(B, Sq, D)),
            "k_cache": _w((lambda *s: torch.randn(*s, dtype=torch.bfloat16) * 3.2)(B, Hkv, Sk, Dh)),
            "v_cache": _w((lambda *s: torch.randn(*s, dtype=torch.bfloat16) * 0.8)(B, Hkv, Sk, Dh)),
            "wq": _w((lambda *s: torch.randn(*s, dtype=torch.bfloat16) * 3.2)(D, Hq * Dh) * (D ** -0.5)),
            "wo": _w((lambda *s: torch.randn(*s, dtype=torch.bfloat16) * 0.8)(Hq * Dh, D) * ((Hq * Dh) ** -0.5)),
        }
    _A_in = _A_setup()

    def _B_setup():
        B, S, D, F = 2, 1, 512, 1792
        return {
            "x": _w((lambda *s: torch.randn(*s, dtype=torch.bfloat16) * 0.05)(B, S, D)),
            "w1": _w((lambda *s: torch.randn(*s, dtype=torch.bfloat16) * 3.2)(D, F) * (D ** -0.5)),
            "b1": _w((lambda *s: torch.randn(*s, dtype=torch.bfloat16) * 3.2)(F) * 0.01),
            "w2": _w((lambda *s: torch.randn(*s, dtype=torch.bfloat16) * 0.4)(F, D) * (F ** -0.5)),
            "b2": _w((lambda *s: torch.randn(*s, dtype=torch.bfloat16) * 0.4)(D) * 0.01),
        }
    _B_in = _B_setup()

    return {
        "A_x": _A_in["x"],
        "A_k_cache": _A_in["k_cache"],
        "A_v_cache": _A_in["v_cache"],
        "A_wq": _A_in["wq"],
        "A_wo": _A_in["wo"],
        "B_x": _B_in["x"],
        "B_w1": _B_in["w1"],
        "B_b1": _B_in["b1"],
        "B_w2": _B_in["w2"],
        "B_b2": _B_in["b2"],
    }

def reference(A_x, A_k_cache, A_v_cache, A_wq, A_wo, B_x, B_w1, B_b1, B_w2, B_b2):
    def _A_ref(x, k_cache, v_cache, wq, wo):
        B, Sq, D = x.shape
        Hq, Dh = 32, 128
        Hkv, Sk = k_cache.shape[1], k_cache.shape[2]
        W = min(4096, max(256, Sk // 4))
        rep = Hq // Hkv
        q = (lambda x, *d: x.permute(*d))((x @ wq).reshape(B, Sq, Hq, Dh), 0, 2, 1, 3)
        k = (lambda x, n, axis: torch.repeat_interleave(x, n, dim=axis))(k_cache[:, :, Sk - W:, :], rep, axis=1)
        v = (lambda x, n, axis: torch.repeat_interleave(x, n, dim=axis))(v_cache[:, :, Sk - W:, :], rep, axis=1)
        scores = torch.einsum("bhqd,bhkd->bhqk", q, k) * (Dh ** -0.5)
        p = _softmax(scores, axis=-1)
        o = torch.einsum("bhqk,bhkd->bhqd", p, v)
        return (lambda x, *d: x.permute(*d))(o, 0, 2, 1, 3).reshape(B, Sq, Hq * Dh) @ wo

    def _B_ref(x, w1, b1, w2, b2):
        h = torch.einsum("bsd,df->bsf", x, w1) + b1
        h = _gelu(h)
        return torch.einsum("bsf,fd->bsd", h, w2) + b2

    x = A_x
    h = x + _A_ref(_layernorm(x, axis=-1), A_k_cache, A_v_cache, A_wq, A_wo)
    h2 = h + _B_ref(_layernorm(h, axis=-1), B_w1, B_b1, B_w2, B_b2)
    return h2
```

```asm
; @launch grid=(256,1,1) block=(576,1,1) lds=59648
.amdgcn_target "amdgcn-amd-amdhsa--gfx950"
.text
.globl sequential_preLN__sliding_block_cached__dense_activation_gelu__decode_kernel
.p2align 8
.type sequential_preLN__sliding_block_cached__dense_activation_gelu__decode_kernel,@function
sequential_preLN__sliding_block_cached__dense_activation_gelu__decode_kernel:
    s_cmp_ge_u32 s2, 256
    s_cbranch_scc1 L_end
    s_load_dwordx16 s[4:19], s[0:1], 0
    s_load_dwordx8 s[20:27], s[0:1], 64
    s_load_dwordx2 s[28:29], s[0:1], 96
    v_lshrrev_b32 v1, 6, v0
    s_nop 0
    v_readfirstlane_b32 s3, v1
    v_and_b32 v1, 63, v0
    s_and_b32 s30, s2, 7
    s_lshr_b32 s31, s2, 3
    s_lshr_b32 s32, s31, 4
    s_and_b32 s33, s31, 15
    s_lshr_b32 s34, s31, 1
    s_mul_i32 s35, s30, 14
    s_add_u32 s35, s35, s34
    s_and_b32 s55, s31, 1
    s_cmp_ge_u32 s34, 14
    s_cselect_b32 s36, 2, 1
    s_mul_i32 s55, s55, s36
    s_cmp_ge_u32 s31, 24
    s_cselect_b32 s56, 1, 0
    s_cmp_eq_u32 s55, 0
    s_cselect_b32 s56, s56, 0
    s_and_b32 s57, s34, 3
    s_lshl_b32 s57, s57, 3
    s_add_u32 s57, s57, s30
    s_mov_b32 s62, 2000000
    s_mov_b32 s40, 0x05040100
    s_mov_b32 s41, 0x07060302
    v_and_b32 v4, 15, v1
    v_lshrrev_b32 v5, 4, v1
    v_lshlrev_b32 v2, 4, v1
    v_mov_b32 v12, -1
    v_mov_b32 v13, -1
    v_mov_b32 v14, -1
    v_mov_b32 v15, -1
    v_mov_b32 v10, 1
    v_mov_b32 v11, 0
    s_cmp_eq_u32 s3, 0
    s_cbranch_scc1 L_comm
    s_sub_u32 s3, s3, 1
    v_subrev_u32 v0, 64, v0
    v_lshrrev_b32 v3, 3, v0
    s_lshr_b32 s38, s31, 3
    s_lshl_b32 s36, s38, 6
    v_add_lshl_u32 v22, v3, s36, 2
    v_lshlrev_b32 v3, 14, v3
    v_and_b32 v6, 7, v0
    v_lshl_add_u32 v3, v6, 4, v3
    s_lshl_b32 s36, s30, 10
    s_and_b32 s37, s31, 7
    s_lshl_b32 s37, s37, 7
    s_add_u32 s36, s36, s37
    s_lshl_b32 s37, s38, 20
    s_add_u32 s36, s36, s37
    v_add_u32 v3, s36, v3
    v_add_u32 v6, 8192, v3
    v_and_b32 v8, 3, v1
    s_lshl_b32 s36, s30, 1
    s_add_u32 s36, s36, s32
    s_lshl_b32 s36, s36, 3
    s_add_u32 s36, s36, s3
    s_lshl_b32 s36, s36, 4
    s_add_u32 s36, s36, s33
    s_lshl_b32 s36, s36, 8
    s_add_u32 s36, s36, 524288
    v_lshlrev_b32 v21, 6, v8
    v_lshl_add_u32 v21, v5, 4, v21
    v_add_u32 v21, s36, v21
    s_lshr_b32 s51, s31, 2
    s_and_b32 s52, s34, 1
    s_and_b32 s53, s3, 3
    s_lshr_b32 s50, s3, 2
    s_lshl_b32 s36, s32, 3
    s_add_u32 s36, s36, s30
    s_lshl_b32 s36, s36, 21
    s_lshl_b32 s37, s33, 15
    s_add_u32 s36, s36, s37
    s_lshl_b32 s37, s3, 12
    s_add_u32 s36, s36, s37
    s_add_u32 s54, s36, 0x180000
    s_waitcnt lgkmcnt(0)
    s_load_dwordx2 s[60:61], s[28:29], 0
    global_load_dwordx4 v[92:95], v3, s[10:11] nt
    global_load_dwordx4 v[96:99], v6, s[10:11] nt
    s_mov_b32 exec_lo, 0x000f000f
    s_mov_b32 exec_hi, 0x000f000f
    global_store_dwordx4 v21, v[12:15], s[28:29] sc1
    v_add_u32 v26, 2097152, v21
    global_store_dwordx4 v26, v[12:15], s[28:29] sc1
    s_mov_b64 exec, -1
    s_cmp_eq_u32 s56, 0
    s_cbranch_scc1 L_noredclr
    s_mov_b32 s38, s57
    s_lshl_b32 s36, s38, 13
    s_lshl_b32 s37, s3, 10
    s_add_u32 s36, s36, s37
    s_add_u32 s36, s36, 1048576
    v_add_u32 v3, s36, v2
    global_store_dwordx4 v3, v[12:15], s[28:29] sc1
    s_lshl_b32 s36, s38, 14
    s_lshl_b32 s37, s3, 11
    s_add_u32 s36, s36, s37
    s_add_u32 s36, s36, 1310720
    v_add_u32 v3, s36, v2
    global_store_dwordx4 v3, v[12:15], s[28:29] sc1
    global_store_dwordx4 v3, v[12:15], s[28:29] offset:1024 sc1
    s_nop 1
L_noredclr:
    s_barrier
    v_lshlrev_b32 v8, 10, v8
    v_bfe_u32 v9, v1, 2, 2
    v_lshl_add_u32 v8, v9, 8, v8
    v_lshl_add_u32 v8, v5, 4, v8
    v_add_u32 v8, s54, v8
    v_add_u32 v9, s54, v2
    global_load_dwordx4 v[28:31], v9, s[6:7] offset:0 nt
    global_load_dwordx4 v[32:35], v9, s[6:7] offset:1024 nt
    global_load_dwordx4 v[36:39], v9, s[6:7] offset:2048 nt
    global_load_dwordx4 v[40:43], v9, s[6:7] offset:3072 nt
    global_load_dwordx4 v[44:47], v9, s[8:9] offset:0 nt
    v_lshrrev_b32 v6, 1, v5
    v_lshlrev_b32 v6, 8, v6
    v_and_b32 v3, 1, v5
    v_lshl_add_u32 v6, v3, 4, v6
    v_and_b32 v3, 7, v1
    v_lshl_add_u32 v6, v3, 5, v6
    s_lshl_b32 s36, s3, 9
    v_add_u32 v6, s36, v6
    s_barrier
    ds_read2st64_b32 v[156:157], v22 offset0:17 offset1:21
    s_waitcnt vmcnt(5)
L_p1:
    v_perm_b32 v148, v96, v92, s40
    v_perm_b32 v149, v96, v92, s41
    v_perm_b32 v150, v97, v93, s40
    v_perm_b32 v151, v97, v93, s41
    v_perm_b32 v152, v98, v94, s40
    v_perm_b32 v153, v98, v94, s41
    v_perm_b32 v154, v99, v95, s40
    v_perm_b32 v155, v99, v95, s41
    s_waitcnt lgkmcnt(0)
    v_dot2_f32_bf16 v132, v148, v156, 0
    v_dot2_f32_bf16 v133, v149, v156, 0
    v_dot2_f32_bf16 v134, v150, v156, 0
    v_dot2_f32_bf16 v135, v151, v156, 0
    v_dot2_f32_bf16 v136, v152, v156, 0
    v_dot2_f32_bf16 v137, v153, v156, 0
    v_dot2_f32_bf16 v138, v154, v156, 0
    v_dot2_f32_bf16 v139, v155, v156, 0
    v_dot2_f32_bf16 v140, v148, v157, 0
    v_dot2_f32_bf16 v141, v149, v157, 0
    v_dot2_f32_bf16 v142, v150, v157, 0
    v_dot2_f32_bf16 v143, v151, v157, 0
    v_dot2_f32_bf16 v144, v152, v157, 0
    v_dot2_f32_bf16 v145, v153, v157, 0
    v_dot2_f32_bf16 v146, v154, v157, 0
    v_dot2_f32_bf16 v147, v155, v157, 0
    v_permlane32_swap_b32 v132, v140
    v_permlane32_swap_b32 v133, v141
    v_permlane32_swap_b32 v134, v142
    v_permlane32_swap_b32 v135, v143
    v_permlane32_swap_b32 v136, v144
    v_permlane32_swap_b32 v137, v145
    v_permlane32_swap_b32 v138, v146
    v_permlane32_swap_b32 v139, v147
    v_pk_add_f32 v[132:133], v[132:133], v[140:141]
    v_pk_add_f32 v[134:135], v[134:135], v[142:143]
    v_pk_add_f32 v[136:137], v[136:137], v[144:145]
    v_pk_add_f32 v[138:139], v[138:139], v[146:147]
    s_nop 0
    v_permlane16_swap_b32 v132, v136
    v_permlane16_swap_b32 v133, v137
    v_permlane16_swap_b32 v134, v138
    v_permlane16_swap_b32 v135, v139
    v_pk_add_f32 v[132:133], v[132:133], v[136:137]
    v_pk_add_f32 v[134:135], v[134:135], v[138:139]
    s_nop 0
    v_add_f32_dpp v132, v132, v132 row_ror:8 row_mask:0xf bank_mask:0xf
    v_add_f32_dpp v133, v133, v133 row_ror:8 row_mask:0xf bank_mask:0xf
    v_add_f32_dpp v134, v134, v134 row_ror:8 row_mask:0xf bank_mask:0xf
    v_add_f32_dpp v135, v135, v135 row_ror:8 row_mask:0xf bank_mask:0xf
    s_mov_b32 exec_lo, 0x00ff00ff
    s_mov_b32 exec_hi, 0x00ff00ff
    ds_write_b128 v6, v[132:135] offset:6400
    s_mov_b64 exec, -1
    s_waitcnt lgkmcnt(0)
    s_barrier
    s_barrier
    global_load_dwordx4 v[48:51], v9, s[8:9] offset:1024 nt
    global_load_dwordx4 v[52:55], v9, s[8:9] offset:2048 nt
    global_load_dwordx4 v[56:59], v9, s[8:9] offset:3072 nt
    v_and_b32 v3, 3, v1
    v_lshrrev_b32 v15, 5, v0
    v_mul_u32_u24 v15, 144, v15
    v_and_b32 v6, 31, v0
    v_lshl_add_u32 v15, v6, 2, v15
    s_mov_b32 s36, 0x3db504f3
    s_mov_b32 s37, 0x3fb8aa3b
    v_and_b32 v6, 3, v4
    v_lshlrev_b32 v12, 5, v6
    s_lshl_b32 s38, s3, 2
    v_add_u32 v13, s38, v12
    v_mul_u32_u24 v6, 272, v6
    v_lshl_add_u32 v6, v5, 4, v6
    s_mov_b32 s64, 0x000f000f
    s_mov_b32 s65, 0x000f000f
    s_mov_b32 s66, 0x00f000f0
    s_mov_b32 s67, 0x00f000f0
    s_mov_b32 s68, 0x0f000f00
    s_mov_b32 s69, 0x0f000f00
    s_mov_b32 s98, 0xf000f000
    s_mov_b32 s99, 0xf000f000
    v_mul_u32_u24 v14, 144, v4
    v_lshl_add_u32 v14, v5, 5, v14
    s_mul_i32 s38, s3, 2304
    v_add_u32 v14, s38, v14
    s_lshl_b32 s38, s30, 15
    s_lshl_b32 s39, s32, 14
    s_add_u32 s38, s38, s39
    s_lshl_b32 s39, s3, 9
    s_add_u32 s38, s38, s39
    s_add_u32 s38, s38, 262144
    v_and_b32 v18, 31, v1
    v_lshrrev_b32 v19, 5, v1
    v_lshlrev_b32 v19, 13, v19
    v_lshl_add_u32 v19, v18, 4, v19
    v_add_u32 v19, s38, v19
    v_add_u32 v22, 4096, v19
    s_lshr_b32 s38, s3, 1
    s_mul_i32 s38, s38, 272
    s_and_b32 s39, s3, 1
    s_lshl_b32 s39, s39, 7
    s_add_u32 s38, s38, s39
    v_lshlrev_b32 v18, 2, v18
    v_add_u32 v18, s38, v18
    s_add_u32 s60, s60, 1
    s_addc_u32 s61, s61, 0
    s_lshl_b32 s38, s3, 12
    s_add_u32 s38, s38, 26880
    s_waitcnt vmcnt(4)
    v_add_u32 v24, 0, v5
    v_xor_b32 v25, v24, v4
    v_lshlrev_b32 v25, 4, v25
    v_lshl_add_u32 v25, v24, 8, v25
    v_add_u32 v25, s38, v25
    ds_write_b128 v25, v[28:31]
    v_add_u32 v24, 4, v5
    v_xor_b32 v25, v24, v4
    v_lshlrev_b32 v25, 4, v25
    v_lshl_add_u32 v25, v24, 8, v25
    v_add_u32 v25, s38, v25
    ds_write_b128 v25, v[32:35]
    v_add_u32 v24, 8, v5
    v_xor_b32 v25, v24, v4
    v_lshlrev_b32 v25, 4, v25
    v_lshl_add_u32 v25, v24, 8, v25
    v_add_u32 v25, s38, v25
    ds_write_b128 v25, v[36:39]
    v_add_u32 v24, 12, v5
    v_xor_b32 v25, v24, v4
    v_lshlrev_b32 v25, 4, v25
    v_lshl_add_u32 v25, v24, 8, v25
    v_add_u32 v25, s38, v25
    ds_write_b128 v25, v[40:43]
    v_and_b32 v24, 3, v4
    v_lshrrev_b32 v25, 2, v4
    v_lshl_add_u32 v24, v24, 2, v25
    s_waitcnt lgkmcnt(0)
    v_add_u32 v25, 0, v5
    v_xor_b32 v25, v24, v25
    v_lshlrev_b32 v25, 4, v25
    v_lshl_add_u32 v25, v24, 8, v25
    v_add_u32 v25, s38, v25
    ds_read_b128 v[28:31], v25
    v_add_u32 v25, 4, v5
    v_xor_b32 v25, v24, v25
    v_lshlrev_b32 v25, 4, v25
    v_lshl_add_u32 v25, v24, 8, v25
    v_add_u32 v25, s38, v25
    ds_read_b128 v[32:35], v25
    v_add_u32 v25, 8, v5
    v_xor_b32 v25, v24, v25
    v_lshlrev_b32 v25, 4, v25
    v_lshl_add_u32 v25, v24, 8, v25
    v_add_u32 v25, s38, v25
    ds_read_b128 v[36:39], v25
    v_add_u32 v25, 12, v5
    v_xor_b32 v25, v24, v25
    v_lshlrev_b32 v25, 4, v25
    v_lshl_add_u32 v25, v24, 8, v25
    v_add_u32 v25, s38, v25
    ds_read_b128 v[40:43], v25
    s_waitcnt vmcnt(0)
    global_load_dwordx4 v[132:135], v19, s[28:29] sc1
    global_load_dwordx4 v[136:139], v22, s[28:29] sc1
    v_perm_b32 v100, v48, v44, s40
    v_perm_b32 v101, v56, v52, s40
    v_perm_b32 v102, v48, v44, s40
    v_perm_b32 v103, v56, v52, s40
    v_perm_b32 v104, v48, v44, s41
    v_perm_b32 v105, v56, v52, s41
    v_perm_b32 v106, v48, v44, s41
    v_perm_b32 v107, v56, v52, s41
    v_perm_b32 v108, v49, v45, s40
    v_perm_b32 v109, v57, v53, s40
    v_perm_b32 v110, v49, v45, s40
    v_perm_b32 v111, v57, v53, s40
    v_perm_b32 v112, v49, v45, s41
    v_perm_b32 v113, v57, v53, s41
    v_perm_b32 v114, v49, v45, s41
    v_perm_b32 v115, v57, v53, s41
    v_perm_b32 v116, v50, v46, s40
    v_perm_b32 v117, v58, v54, s40
    v_perm_b32 v118, v50, v46, s40
    v_perm_b32 v119, v58, v54, s40
    v_perm_b32 v120, v50, v46, s41
    v_perm_b32 v121, v58, v54, s41
    v_perm_b32 v122, v50, v46, s41
    v_perm_b32 v123, v58, v54, s41
    v_perm_b32 v124, v51, v47, s40
    v_perm_b32 v125, v59, v55, s40
    v_perm_b32 v126, v51, v47, s40
    v_perm_b32 v127, v59, v55, s40
    v_perm_b32 v128, v51, v47, s41
    v_perm_b32 v129, v59, v55, s41
    v_perm_b32 v130, v51, v47, s41
    v_perm_b32 v131, v59, v55, s41
    s_nop 0
    s_branch L_qchk
L_poll_q:
    global_load_dwordx4 v[132:135], v19, s[28:29] sc1
    global_load_dwordx4 v[136:139], v22, s[28:29] sc1
L_qchk:
    s_waitcnt vmcnt(0)
    v_cmp_ne_u64 vcc, s[60:61], v[134:135]
    v_cmp_ne_u64 s[38:39], s[60:61], v[138:139]
    s_or_b64 vcc, vcc, s[38:39]
    s_nop 2
    s_cbranch_vccz L_poll_q_ok
    s_sub_u32 s62, s62, 1
    s_cmp_gt_i32 s62, 0
    s_cbranch_scc1 L_poll_q
L_poll_q_ok:
    v_pk_add_f32 v[132:133], v[132:133], v[136:137]
    v_mov_b32 v134, v132
    v_mov_b32 v135, v133
    s_nop 0
    v_permlane32_swap_b32 v132, v134
    v_permlane32_swap_b32 v133, v135
    v_pk_add_f32 v[132:133], v[132:133], v[134:135]
    v_cvt_pk_bf16_f32 v132, v132, v133
    s_mov_b32 exec_hi, 0
    ds_write_b32 v18, v132 offset:1024
    s_mov_b32 exec_hi, -1
    s_cmp_lg_u32 s55, 0
    s_cbranch_scc1 Lwe_1
    s_lshl_b32 s44, s30, 19
    s_lshl_b32 s45, s51, 14
    s_add_u32 s44, s44, s45
    s_lshl_b32 s45, s52, 9
    s_add_u32 s44, s44, s45
    s_lshl_b32 s45, s3, 6
    s_add_u32 s44, s44, s45
    v_lshlrev_b32 v20, 17, v5
    v_bfe_u32 v16, v1, 2, 2
    v_lshl_add_u32 v20, v16, 12, v20
    v_and_b32 v16, 3, v1
    v_lshl_add_u32 v20, v16, 4, v20
    v_add_u32 v20, s44, v20
    global_load_dwordx4 v[60:63], v20, s[12:13] offset:0 nt
    global_load_dwordx4 v[64:67], v20, s[12:13] offset:1024 nt
    global_load_dwordx4 v[68:71], v20, s[12:13] offset:2048 nt
    global_load_dwordx4 v[72:75], v20, s[12:13] offset:3072 nt
Lwe_1:
    s_waitcnt lgkmcnt(0)
    s_barrier
    ds_read_b128 v[132:135], v6 offset:1024
    ds_read_b128 v[136:139], v6 offset:1088
    ds_read_b128 v[140:143], v6 offset:1152
    ds_read_b128 v[144:147], v6 offset:1216
    s_waitcnt lgkmcnt(3)
    v_mfma_f32_16x16x32_bf16 v[148:151], v[28:31], v[132:135], 0
    s_waitcnt lgkmcnt(2)
    v_mfma_f32_16x16x32_bf16 v[148:151], v[32:35], v[136:139], v[148:151]
    s_waitcnt lgkmcnt(1)
    v_mfma_f32_16x16x32_bf16 v[148:151], v[36:39], v[140:143], v[148:151]
    s_waitcnt lgkmcnt(0)
    v_mfma_f32_16x16x32_bf16 v[148:151], v[40:43], v[144:147], v[148:151]
    s_nop 7
    v_cvt_pk_bf16_f32 v156, v148, v149
    v_cvt_pk_bf16_f32 v157, v150, v151
    v_lshlrev_b32 v152, 16, v156
    v_and_b32 v153, 0xffff0000, v156
    v_lshlrev_b32 v154, 16, v157
    v_and_b32 v155, 0xffff0000, v157
    v_mul_f32 v152, s36, v152
    v_mul_f32 v153, s36, v153
    v_mul_f32 v154, s36, v154
    v_mul_f32 v155, s36, v155
    v_cvt_pk_bf16_f32 v156, v152, v153
    v_cvt_pk_bf16_f32 v157, v154, v155
    v_lshlrev_b32 v152, 16, v156
    v_and_b32 v153, 0xffff0000, v156
    v_lshlrev_b32 v154, 16, v157
    v_and_b32 v155, 0xffff0000, v157
    v_max3_f32 v160, v152, v153, v154
    v_max_f32 v160, v160, v155
    v_mov_b32 v156, v160
    s_nop 1
    v_permlane16_swap_b32 v160, v156
    v_max_f32 v160, v160, v156
    v_mov_b32 v156, v160
    s_nop 1
    v_permlane32_swap_b32 v160, v156
    v_max_f32 v160, v160, v156
    s_mov_b64 exec, 15
    ds_write_b32 v13, v160 offset:512
    s_mov_b64 exec, -1
    s_waitcnt lgkmcnt(0)
    s_barrier
    ds_read_b128 v[132:135], v12 offset:512
    ds_read_b128 v[136:139], v12 offset:528
    s_waitcnt lgkmcnt(0)
    v_max3_f32 v160, v132, v133, v134
    v_max3_f32 v156, v135, v136, v137
    v_max3_f32 v160, v160, v138, v139
    v_max_f32 v160, v160, v156
    v_sub_f32 v152, v152, v160
    v_sub_f32 v153, v153, v160
    v_sub_f32 v154, v154, v160
    v_sub_f32 v155, v155, v160
    v_mul_f32 v152, s37, v152
    v_mul_f32 v153, s37, v153
    v_mul_f32 v154, s37, v154
    v_mul_f32 v155, s37, v155
    v_exp_f32 v152, v152
    v_exp_f32 v153, v153
    v_exp_f32 v154, v154
    v_exp_f32 v155, v155
    v_cvt_pk_bf16_f32 v164, v152, v153
    v_cvt_pk_bf16_f32 v165, v154, v155
    v_lshlrev_b32 v156, 16, v164
    v_and_b32 v157, 0xffff0000, v164
    v_lshlrev_b32 v158, 16, v165
    v_and_b32 v159, 0xffff0000, v165
    v_sub_f32 v156, v152, v156
    v_sub_f32 v157, v153, v157
    v_sub_f32 v158, v154, v158
    v_sub_f32 v159, v155, v159
    v_cvt_pk_bf16_f32 v166, v156, v157
    v_cvt_pk_bf16_f32 v167, v158, v159
    v_cndmask_b32 v44, 0, v164, s[64:65]
    v_cndmask_b32 v45, 0, v165, s[64:65]
    v_cndmask_b32 v46, 0, v166, s[64:65]
    v_cndmask_b32 v47, 0, v167, s[64:65]
    s_nop 1
    v_mfma_f32_16x16x32_bf16 v[28:31], v[44:47], v[100:103], 0
    v_mfma_f32_16x16x32_bf16 v[32:35], v[44:47], v[104:107], 0
    v_cndmask_b32 v48, 0, v164, s[66:67]
    v_cndmask_b32 v49, 0, v165, s[66:67]
    v_cndmask_b32 v50, 0, v166, s[66:67]
    v_cndmask_b32 v51, 0, v167, s[66:67]
    s_nop 1
    v_mfma_f32_16x16x32_bf16 v[28:31], v[48:51], v[108:111], v[28:31]
    v_mfma_f32_16x16x32_bf16 v[32:35], v[48:51], v[112:115], v[32:35]
    v_cndmask_b32 v52, 0, v164, s[68:69]
    v_cndmask_b32 v53, 0, v165, s[68:69]
    v_cndmask_b32 v54, 0, v166, s[68:69]
    v_cndmask_b32 v55, 0, v167, s[68:69]
    s_nop 1
    v_mfma_f32_16x16x32_bf16 v[28:31], v[52:55], v[116:119], v[28:31]
    v_mfma_f32_16x16x32_bf16 v[32:35], v[52:55], v[120:123], v[32:35]
    v_cndmask_b32 v56, 0, v164, s[98:99]
    v_cndmask_b32 v57, 0, v165, s[98:99]
    v_cndmask_b32 v58, 0, v166, s[98:99]
    v_cndmask_b32 v59, 0, v167, s[98:99]
    s_nop 1
    v_mfma_f32_16x16x32_bf16 v[28:31], v[56:59], v[124:127], v[28:31]
    v_mfma_f32_16x16x32_bf16 v[32:35], v[56:59], v[128:131], v[32:35]
    v_add_f32 v161, v152, v153
    v_add_f32 v156, v154, v155
    v_add_f32 v161, v161, v156
    v_mov_b32 v156, v161
    s_nop 1
    v_permlane16_swap_b32 v161, v156
    v_add_f32 v161, v161, v156
    ds_write_b128 v14, v[28:31] offset:6400
    ds_write_b128 v14, v[32:35] offset:6416
    v_mov_b32 v156, v161
    s_nop 1
    v_permlane32_swap_b32 v161, v156
    v_add_f32 v161, v161, v156
    s_mov_b64 exec, 15
    ds_write_b32 v13, v161 offset:640
    s_mov_b64 exec, -1
L_b3:
    s_waitcnt lgkmcnt(0)
    s_barrier
    ds_read2st64_b32 v[132:133], v15 offset0:25 offset1:34
    ds_read2st64_b32 v[134:135], v15 offset0:43 offset1:52
    ds_read2st64_b32 v[136:137], v15 offset0:61 offset1:70
    ds_read2st64_b32 v[138:139], v15 offset0:79 offset1:88
    s_waitcnt lgkmcnt(2)
    v_pk_add_f32 v[132:133], v[132:133], v[134:135]
    s_waitcnt lgkmcnt(0)
    v_pk_add_f32 v[136:137], v[136:137], v[138:139]
    v_pk_add_f32 v[132:133], v[132:133], v[136:137]
    v_add_f32 v140, v132, v133
    v_min_u32 v140, -2, v140
    s_nop 1
    v_mov_b32_dpp v141, v140 row_shl:4 row_mask:0xf bank_mask:0xf
    v_mov_b32_dpp v142, v140 row_shl:8 row_mask:0xf bank_mask:0xf
    v_mov_b32_dpp v143, v140 row_shl:12 row_mask:0xf bank_mask:0xf
    s_mov_b32 exec_lo, 0x000f000f
    s_mov_b32 exec_hi, 0x000f000f
    global_store_dwordx4 v26, v[140:143], s[28:29]
    global_store_dwordx4 v21, v[140:143], s[28:29] sc1
    s_mov_b64 exec, -1
    s_cmp_eq_u32 s55, 1
    s_cbranch_scc1 L_mlp
    s_cmp_eq_u32 s55, 2
    s_cbranch_scc1 L_data_end
    v_and_b32 v3, 3, v1
    s_lshl_b32 s44, s30, 1
    s_add_u32 s44, s44, s50
    s_lshl_b32 s45, s44, 3
    s_add_u32 s45, s45, s51
    s_lshl_b32 s45, s45, 12
    s_lshl_b32 s46, s53, 6
    s_add_u32 s45, s45, s46
    s_add_u32 s45, s45, 524288
    v_lshrrev_b32 v18, 2, v1
    v_lshlrev_b32 v17, 8, v18
    v_lshl_add_u32 v17, v3, 4, v17
    v_add_u32 v17, s45, v17
    v_bfe_u32 v22, v1, 2, 1
    v_lshlrev_b32 v22, 7, v22
    v_lshl_add_u32 v22, v5, 4, v22
    s_lshl_b32 s45, s3, 5
    v_lshlrev_b32 v23, 3, v3
    v_lshrrev_b32 v16, 5, v1
    v_lshl_add_u32 v23, v16, 2, v23
    v_add_u32 v23, s45, v23
    s_lshl_b32 s44, s44, 11
    s_lshl_b32 s46, s53, 3
    s_add_u32 s44, s44, s46
    s_add_u32 s44, s44, 131072
    v_lshlrev_b32 v18, 7, v18
    v_add_u32 v18, s44, v18
    s_lshl_b32 s44, s52, 3
    s_add_u32 s44, s44, s3
    s_lshl_b32 s44, s44, 13
    s_lshl_b32 s45, s30, 3
    s_add_u32 s45, s45, s51
    s_lshl_b32 s45, s45, 7
    s_add_u32 s44, s44, s45
    s_add_u32 s44, s44, 1048576
    v_lshlrev_b32 v19, 3, v4
    v_lshl_add_u32 v19, v5, 17, v19
    v_add_u32 v19, s44, v19
    s_waitcnt vmcnt(2)
    v_add_u32 v24, 2097152, v17
    v_add_u32 v25, 2097152, v18
    global_load_dwordx4 v[132:135], v24, s[28:29] sc1
    global_load_dwordx2 v[136:137], v25, s[28:29] sc1
    s_lshl_b32 s44, s3, 12
    s_add_u32 s44, s44, 26880
    v_lshrrev_b32 v16, 2, v1
    v_lshlrev_b32 v16, 8, v16
    v_and_b32 v20, 3, v1
    v_lshl_add_u32 v16, v20, 4, v16
    v_add_u32 v16, s44, v16
    ds_write_b128 v16, v[60:63] offset:0
    ds_write_b128 v16, v[64:67] offset:64
    ds_write_b128 v16, v[68:71] offset:128
    ds_write_b128 v16, v[72:75] offset:192
    v_lshlrev_b32 v16, 9, v5
    v_lshl_add_u32 v16, v4, 2, v16
    v_add_u32 v16, s44, v16
    v_add_u32 v20, 2048, v16
    s_waitcnt lgkmcnt(0)
    ds_read2_b32 v[60:61], v16 offset0:0 offset1:16
    ds_read2_b32 v[62:63], v16 offset0:32 offset1:48
    ds_read2_b32 v[64:65], v16 offset0:64 offset1:80
    ds_read2_b32 v[66:67], v16 offset0:96 offset1:112
    ds_read2_b32 v[68:69], v20 offset0:0 offset1:16
    ds_read2_b32 v[70:71], v20 offset0:32 offset1:48
    ds_read2_b32 v[72:73], v20 offset0:64 offset1:80
    ds_read2_b32 v[74:75], v20 offset0:96 offset1:112
    s_waitcnt lgkmcnt(0)
    v_perm_b32 v100, v61, v60, s40
    v_perm_b32 v101, v63, v62, s40
    v_perm_b32 v102, v65, v64, s40
    v_perm_b32 v103, v67, v66, s40
    v_perm_b32 v104, v61, v60, s41
    v_perm_b32 v105, v63, v62, s41
    v_perm_b32 v106, v65, v64, s41
    v_perm_b32 v107, v67, v66, s41
    v_perm_b32 v108, v69, v68, s40
    v_perm_b32 v109, v71, v70, s40
    v_perm_b32 v110, v73, v72, s40
    v_perm_b32 v111, v75, v74, s40
    v_perm_b32 v112, v69, v68, s41
    v_perm_b32 v113, v71, v70, s41
    v_perm_b32 v114, v73, v72, s41
    v_perm_b32 v115, v75, v74, s41
    v_add_u32 v24, 2097152, v17
    v_add_u32 v25, 2097152, v18
    s_mov_b32 s59, 9
    s_branch L_h2chk
L_poll_h2:
    s_sub_u32 s59, s59, 1
    s_cmp_eq_u32 s59, 0
    s_cbranch_scc1 L_poll_h2b
    global_load_dwordx4 v[132:135], v24, s[28:29] sc1
    global_load_dwordx2 v[136:137], v25, s[28:29] sc1
    s_branch L_h2chk
L_poll_h2b:
    s_mov_b32 s59, 9
    global_load_dwordx4 v[132:135], v17, s[28:29] sc1
    global_load_dwordx2 v[136:137], v18, s[28:29] sc1
L_h2chk:
    s_waitcnt vmcnt(0)
    v_max3_u32 v138, v132, v133, v134
    v_max3_u32 v138, v138, v135, v136
    v_max_u32 v138, v138, v137
    v_cmp_eq_u32 vcc, -1, v138
    s_nop 0
    s_cbranch_vccz L_poll_h2_ok
    s_sub_u32 s62, s62, 1
    s_cmp_gt_i32 s62, 0
    s_cbranch_scc1 L_poll_h2
L_poll_h2_ok:
    v_max_f32_dpp v138, v136, v136 row_ror:4 row_mask:0xf bank_mask:0xf
    s_nop 1
    v_max_f32_dpp v138, v138, v138 row_ror:8 row_mask:0xf bank_mask:0xf
    v_mov_b32 v139, v138
    s_nop 1
    v_permlane16_swap_b32 v138, v139
    v_max_f32 v138, v138, v139
    v_mov_b32 v139, v138
    s_nop 1
    v_permlane32_swap_b32 v138, v139
    v_max_f32 v138, v138, v139
    v_sub_f32 v136, v136, v138
    v_mul_f32 v136, s37, v136
    v_exp_f32 v136, v136
    s_nop 0
    v_mul_f32 v132, v136, v132
    v_mul_f32 v133, v136, v133
    v_mul_f32 v134, v136, v134
    v_mul_f32 v135, v136, v135
    v_mul_f32 v138, v136, v137
    v_mov_b32 v139, v138
    v_permlane32_swap_b32 v132, v134
    v_permlane32_swap_b32 v133, v135
    v_permlane32_swap_b32 v138, v139
    v_pk_add_f32 v[132:133], v[132:133], v[134:135]
    v_add_f32 v138, v138, v139
    v_mov_b32 v139, v138
    v_permlane16_swap_b32 v132, v133
    s_nop 0
    v_permlane16_swap_b32 v138, v139
    v_add_f32 v132, v132, v133
    v_add_f32 v138, v138, v139
    s_nop 0
    v_add_f32_dpp v132, v132, v132 row_ror:4 row_mask:0xf bank_mask:0xf
    v_add_f32_dpp v138, v138, v138 row_ror:4 row_mask:0xf bank_mask:0xf
    s_nop 0
    v_add_f32_dpp v132, v132, v132 row_ror:8 row_mask:0xf bank_mask:0xf
    v_add_f32_dpp v138, v138, v138 row_ror:8 row_mask:0xf bank_mask:0xf
    v_rcp_f32 v139, v138
    s_nop 0
    v_mul_f32 v133, v132, v139
    v_fma_f32 v134, -v133, v138, v132
    v_fmac_f32 v133, v134, v139
    v_mov_b32 v132, v133
    s_nop 1
    v_permlane16_swap_b32 v132, v133
    v_cvt_pk_bf16_f32 v132, v132, v133
    s_mov_b32 exec_lo, 15
    s_mov_b32 exec_hi, 15
    ds_write_b32 v23, v132 offset:0
    s_mov_b64 exec, -1
    s_waitcnt lgkmcnt(0)
    s_barrier
    ds_read_b128 v[148:151], v22 offset:0
    ds_read_b128 v[152:155], v22 offset:64
    s_waitcnt lgkmcnt(1)
    v_mfma_f32_16x16x32_bf16 v[132:135], v[148:151], v[100:103], 0
    v_mfma_f32_16x16x32_bf16 v[136:139], v[148:151], v[104:107], 0
    s_waitcnt lgkmcnt(0)
    v_mfma_f32_16x16x32_bf16 v[132:135], v[152:155], v[108:111], v[132:135]
    v_mfma_f32_16x16x32_bf16 v[136:139], v[152:155], v[112:115], v[136:139]
    s_nop 6
    v_min_u32 v132, -2, v132
    v_min_u32 v133, -2, v136
    s_mov_b32 exec_hi, 0
    global_store_dwordx2 v19, v[132:133], s[28:29] sc1
    s_mov_b32 exec_hi, -1
    s_cmp_eq_u32 s56, 0
    s_cbranch_scc1 L_data_end
    s_lshl_b32 s44, s57, 13
    s_lshl_b32 s45, s3, 10
    s_add_u32 s44, s44, s45
    s_add_u32 s44, s44, 1048576
    v_add_u32 v12, s44, v2
    s_lshl_b32 s44, s57, 14
    s_lshl_b32 s45, s3, 11
    s_add_u32 s44, s44, s45
    s_add_u32 s44, s44, 1310720
    v_add_u32 v13, s44, v2
    v_and_b32 v14, 7, v1
    v_lshl_add_u32 v14, v14, 2, v5
    v_lshlrev_b32 v14, 2, v14
    s_lshl_b32 s45, s3, 7
    v_add_u32 v14, s45, v14
    s_nop 1
L_poll_p:
    global_load_dwordx4 v[132:135], v12, s[28:29] sc1
    s_waitcnt vmcnt(0)
    v_max3_u32 v140, v132, v133, v134
    v_max_u32 v140, v140, v135
    v_cmp_eq_u32 vcc, -1, v140
    s_nop 0
    s_cbranch_vccz L_poll_p_ok
    s_sub_u32 s62, s62, 1
    s_cmp_gt_i32 s62, 0
    s_cbranch_scc1 L_poll_p
L_poll_p_ok:
    v_permlane32_swap_b32 v132, v134
    v_permlane32_swap_b32 v133, v135
    v_pk_add_f32 v[132:133], v[132:133], v[134:135]
    s_nop 1
    v_permlane16_swap_b32 v132, v133
    v_add_f32 v132, v132, v133
    s_nop 1
    v_add_f32_dpp v132, v132, v132 row_ror:8 row_mask:0xf bank_mask:0xf
    ds_write_b32 v14, v132 offset:24832
    s_waitcnt lgkmcnt(0)
    s_barrier
    s_cmp_eq_u32 s3, 7
    s_cbranch_scc1 L_data_end
    s_barrier
L_poll_y:
    global_load_dwordx4 v[132:135], v13, s[28:29] sc1
    global_load_dwordx4 v[136:139], v13, s[28:29] offset:1024 sc1
    s_waitcnt vmcnt(0)
    v_max3_u32 v140, v132, v133, v134
    v_max3_u32 v140, v140, v135, v136
    v_max3_u32 v140, v140, v137, v138
    v_max_u32 v140, v140, v139
    v_cmp_eq_u32 vcc, -1, v140
    s_nop 0
    s_cbranch_vccz L_poll_y_ok
    s_sub_u32 s62, s62, 1
    s_cmp_gt_i32 s62, 0
    s_cbranch_scc1 L_poll_y
L_poll_y_ok:
    v_pk_add_f32 v[132:133], v[132:133], v[136:137]
    v_pk_add_f32 v[134:135], v[134:135], v[138:139]
    s_nop 1
    v_permlane32_swap_b32 v132, v134
    v_permlane32_swap_b32 v133, v135
    v_pk_add_f32 v[132:133], v[132:133], v[134:135]
    s_nop 1
    v_permlane16_swap_b32 v132, v133
    v_add_f32 v132, v132, v133
    s_nop 1
    v_add_f32_dpp v132, v132, v132 row_ror:8 row_mask:0xf bank_mask:0xf
    ds_write_b32 v14, v132 offset:25856
    s_waitcnt lgkmcnt(0)
    s_barrier
    s_branch L_data_end
L_mlp:
    s_mul_i32 s44, s3, 229376
    s_lshl_b32 s45, s35, 5
    s_add_u32 s44, s44, s45
    v_lshrrev_b32 v16, 3, v4
    v_lshl_add_u32 v20, v16, 2, v5
    v_mul_u32_u24 v20, 28672, v20
    v_and_b32 v16, 7, v4
    v_lshl_add_u32 v20, v16, 2, v20
    v_add_u32 v20, s44, v20
    global_load_dword v76, v20, s[16:17] offset:0 nt
    global_load_dword v77, v20, s[16:17] offset:3584 nt
    v_add_u32 v16, 7168, v20
    global_load_dword v78, v16, s[16:17] nt
    v_add_u32 v16, 10752, v20
    global_load_dword v79, v16, s[16:17] nt
    v_add_u32 v16, 14336, v20
    global_load_dword v80, v16, s[16:17] nt
    v_add_u32 v16, 17920, v20
    global_load_dword v81, v16, s[16:17] nt
    v_add_u32 v16, 21504, v20
    global_load_dword v82, v16, s[16:17] nt
    v_add_u32 v16, 25088, v20
    global_load_dword v83, v16, s[16:17] nt
    s_lshl_b32 s44, s35, 14
    s_lshl_b32 s45, s3, 7
    s_add_u32 s44, s44, s45
    v_lshlrev_b32 v20, 12, v5
    v_lshl_add_u32 v20, v4, 3, v20
    v_add_u32 v20, s44, v20
    global_load_dwordx2 v[84:85], v20, s[20:21] offset:0 nt
    global_load_dwordx2 v[86:87], v20, s[20:21] offset:1024 nt
    global_load_dwordx2 v[88:89], v20, s[20:21] offset:2048 nt
    global_load_dwordx2 v[90:91], v20, s[20:21] offset:3072 nt
    v_and_b32 v16, 3, v1
    v_lshl_add_u32 v16, v5, 2, v16
    s_lshl_b32 s44, s35, 4
    v_add_lshl_u32 v17, v16, s44, 1
    global_load_ushort v7, v17, s[18:19]
    v_and_b32 v14, 3, v1
    v_lshl_add_u32 v14, v5, 2, v14
    v_lshlrev_b32 v14, 2, v14
    v_bfe_u32 v3, v1, 2, 1
    v_lshl_add_u32 v14, v3, 6, v14
    v_bfe_u32 v3, v1, 3, 1
    v_lshl_add_u32 v14, v3, 9, v14
    v_add_u32 v14, 2304, v14
    v_and_b32 v16, 1, v1
    v_lshlrev_b32 v16, 3, v16
    v_and_b32 v12, 1, v1
    v_lshlrev_b32 v12, 10, v12
    v_lshl_add_u32 v12, v5, 4, v12
    v_bfe_u32 v3, v1, 1, 1
    v_lshl_add_u32 v12, v3, 6, v12
    s_lshl_b32 s36, s3, 7
    v_add_u32 v12, s36, v12
    v_and_b32 v13, 7, v4
    v_lshlrev_b32 v13, 3, v13
    v_lshrrev_b32 v3, 3, v4
    s_lshl_b32 s36, s3, 7
    s_add_u32 s36, s36, 2304
    v_add_u32 v13, s36, v13
    v_cmp_ne_u32 s[42:43], 0, v3
    v_lshl_add_u32 v15, v5, 4, v3
    s_lshl_b32 s36, s3, 1
    v_add_lshl_u32 v15, v15, s36, 14
    v_and_b32 v3, 7, v4
    v_lshl_add_u32 v15, v3, 4, v15
    s_lshl_b32 s36, s35, 7
    s_add_u32 s36, s36, 1310720
    v_add_u32 v15, s36, v15
    s_mov_b32 s36, 0x3d372713
    s_waitcnt vmcnt(0)
    v_perm_b32 v28, v77, v76, s40
    v_perm_b32 v29, v79, v78, s40
    v_perm_b32 v30, v81, v80, s40
    v_perm_b32 v31, v83, v82, s40
    v_perm_b32 v32, v77, v76, s41
    v_perm_b32 v33, v79, v78, s41
    v_perm_b32 v34, v81, v80, s41
    v_perm_b32 v35, v83, v82, s41
    v_perm_b32 v100, v86, v84, s40
    v_perm_b32 v101, v90, v88, s40
    v_perm_b32 v102, v86, v84, s41
    v_perm_b32 v103, v90, v88, s41
    v_perm_b32 v104, v87, v85, s40
    v_perm_b32 v105, v91, v89, s40
    v_perm_b32 v106, v87, v85, s41
    v_perm_b32 v107, v91, v89, s41
    v_lshlrev_b32 v7, 16, v7
    s_barrier
    ds_read_b128 v[132:135], v12 offset:4352
    s_waitcnt lgkmcnt(0)
    v_mfma_f32_16x16x32_bf16 v[140:143], v[132:135], v[28:31], 0
    v_mfma_f32_16x16x32_bf16 v[144:147], v[132:135], v[32:35], 0
    s_nop 6
    v_cndmask_b32 v140, v140, v142, s[42:43]
    v_cndmask_b32 v141, v141, v143, s[42:43]
    v_cndmask_b32 v144, v144, v146, s[42:43]
    v_cndmask_b32 v145, v145, v147, s[42:43]
    v_add_f32_dpp v140, v140, v140 row_ror:8 row_mask:0xf bank_mask:0xf
    v_add_f32_dpp v141, v141, v141 row_ror:8 row_mask:0xf bank_mask:0xf
    v_add_f32_dpp v144, v144, v144 row_ror:8 row_mask:0xf bank_mask:0xf
    v_add_f32_dpp v145, v145, v145 row_ror:8 row_mask:0xf bank_mask:0xf
    s_mov_b64 exec, 0xff
    ds_write2_b32 v13, v140, v144 offset0:0 offset1:1
    ds_write2_b32 v13, v141, v145 offset0:16 offset1:17
    s_mov_b64 exec, -1
    s_waitcnt lgkmcnt(0)
    s_barrier
    ds_read2_b32 v[132:133], v14 offset0:0 offset1:32
    ds_read2_b32 v[134:135], v14 offset0:64 offset1:96
    s_waitcnt lgkmcnt(0)
    v_pk_add_f32 v[132:133], v[132:133], v[134:135]
    v_add_f32 v148, v132, v133
    s_nop 1
    v_add_f32_dpp v148, v148, v148 row_ror:8 row_mask:0xf bank_mask:0xf
    v_cvt_pk_bf16_f32 v148, v148, v148
    v_lshlrev_b32 v148, 16, v148
    v_add_f32 v148, v148, v7
    v_cvt_pk_bf16_f32 v148, v148, v148
    v_lshlrev_b32 v148, 16, v148
    v_mul_f32 v149, v148, v148
    v_fma_f32 v149, v149, s36, 1.0
    v_mul_f32 v149, v149, v148
    v_mul_f32 v149, 0xc0135761, v149
    v_exp_f32 v149, v149
    s_nop 0
    v_add_f32 v149, 1.0, v149
    v_rcp_f32 v150, v149
    s_nop 0
    v_mul_f32 v148, v148, v150
    s_nop 1
    v_mov_b32_dpp v149, v148 quad_perm:[1,0,3,2] row_mask:0xf bank_mask:0xf
    v_cvt_pk_bf16_f32 v150, v148, v149
    s_nop 1
    v_mov_b32_dpp v152, v150 quad_perm:[0,0,0,0] row_mask:0xf bank_mask:0xf
    v_mov_b32_dpp v153, v150 quad_perm:[2,2,2,2] row_mask:0xf bank_mask:0xf
    s_nop 1
    v_mfma_f32_16x16x16_bf16 v[132:135], v[152:153], v[100:101], 0
    v_mfma_f32_16x16x16_bf16 v[136:139], v[152:153], v[102:103], 0
    v_mfma_f32_16x16x16_bf16 v[140:143], v[152:153], v[104:105], 0
    v_mfma_f32_16x16x16_bf16 v[144:147], v[152:153], v[106:107], 0
    s_nop 4
    v_min_u32 v156, -2, v132
    v_min_u32 v157, -2, v136
    v_min_u32 v158, -2, v140
    v_min_u32 v159, -2, v144
    s_mov_b32 exec_hi, 0
    global_store_dwordx4 v15, v[156:159], s[28:29] sc1
    s_mov_b32 exec_hi, -1
    s_nop 0
L_data_end:
    s_endpgm
L_comm:
    s_setprio 3
    s_mov_b32 s3, 8
    v_mov_b32 v28, 0
    v_mov_b32 v29, 0
    v_mov_b32 v30, 0
    v_mov_b32 v31, 0
    ds_write_b128 v28, v[28:31] offset:2176
    ds_write_b128 v28, v[28:31] offset:2192
    ds_write_b128 v28, v[28:31] offset:2208
    v_lshlrev_b32 v9, 5, v1
    v_and_b32 v3, 3, v1
    v_and_b32 v7, 7, v1
    s_waitcnt lgkmcnt(0)
    global_load_dwordx4 v[24:27], v9, s[4:5]
    global_load_dwordx4 v[28:31], v9, s[4:5] offset:16
    s_load_dwordx2 s[60:61], s[28:29], 0
    s_lshl_b32 s36, s30, 1
    s_add_u32 s36, s36, s32
    s_lshl_b32 s36, s36, 4
    s_add_u32 s36, s36, s33
    s_lshl_b32 s36, s36, 7
    s_add_u32 s36, s36, 131072
    v_add_u32 v6, s36, v2
    v_lshlrev_b32 v17, 3, v1
    v_add_u32 v17, s36, v17
    s_mov_b64 exec, 3
    global_store_dwordx4 v6, v[12:15], s[28:29] sc1
    v_add_u32 v6, 2097152, v6
    global_store_dwordx4 v6, v[12:15], s[28:29] sc1
    s_mov_b64 exec, -1
    s_mov_b32 s39, s57
    v_lshrrev_b32 v18, 3, v1
    v_lshlrev_b32 v18, 12, v18
    v_lshl_add_u32 v18, v7, 3, v18
    s_lshl_b32 s36, s39, 7
    v_add_u32 v19, s36, v18
    v_add_u32 v18, 196608, v19
    v_add_u32 v19, 32768, v19
    s_cmp_eq_u32 s56, 0
    s_cbranch_scc1 L_nohclr
    s_mov_b32 exec_lo, 0x55555555
    s_mov_b32 exec_hi, 0x55555555
    global_store_dwordx4 v18, v[12:15], s[28:29] sc1
    s_mov_b64 exec, -1
    s_lshl_b32 s36, s39, 5
    v_lshl_add_u32 v6, v7, 2, v5
    v_add_lshl_u32 v8, v6, s36, 1
    global_load_ushort v20, v8, s[4:5]
    s_and_b32 s36, s36, 511
    v_add_lshl_u32 v8, v6, s36, 1
    global_load_ushort v21, v8, s[22:23]
    s_nop 0
L_nohclr:
    s_barrier
    s_mov_b32 s36, 0x3f803f80
    s_waitcnt vmcnt(0) lgkmcnt(0)
    v_dot2_f32_bf16 v40, v24, s36, 0
    v_dot2_f32_bf16 v40, v25, s36, v40
    v_dot2_f32_bf16 v40, v26, s36, v40
    v_dot2_f32_bf16 v40, v27, s36, v40
    v_dot2_f32_bf16 v40, v28, s36, v40
    v_dot2_f32_bf16 v40, v29, s36, v40
    v_dot2_f32_bf16 v40, v30, s36, v40
    v_dot2_f32_bf16 v40, v31, s36, v40
    v_lshlrev_b32 v48, 16, v24
    v_and_b32 v49, 0xffff0000, v24
    v_lshlrev_b32 v50, 16, v25
    v_and_b32 v51, 0xffff0000, v25
    v_lshlrev_b32 v52, 16, v26
    v_and_b32 v53, 0xffff0000, v26
    v_lshlrev_b32 v54, 16, v27
    v_and_b32 v55, 0xffff0000, v27
    v_lshlrev_b32 v56, 16, v28
    v_and_b32 v57, 0xffff0000, v28
    v_lshlrev_b32 v58, 16, v29
    v_and_b32 v59, 0xffff0000, v29
    v_lshlrev_b32 v60, 16, v30
    v_and_b32 v61, 0xffff0000, v30
    v_lshlrev_b32 v62, 16, v31
    v_and_b32 v63, 0xffff0000, v31
    v_mov_b32 v41, v40
    s_nop 1
    v_permlane16_swap_b32 v40, v41
    v_add_f32 v40, v40, v41
    s_nop 1
    v_add_f32_dpp v40, v40, v40 row_ror:1 row_mask:0xf bank_mask:0xf
    s_nop 1
    v_add_f32_dpp v40, v40, v40 row_ror:2 row_mask:0xf bank_mask:0xf
    s_nop 1
    v_add_f32_dpp v40, v40, v40 row_ror:4 row_mask:0xf bank_mask:0xf
    s_nop 1
    v_add_f32_dpp v40, v40, v40 row_ror:8 row_mask:0xf bank_mask:0xf
    v_mul_f32 v40, 0x3b000000, v40
    v_sub_f32 v42, 0, v40
    v_mov_b32 v43, v42
    v_pk_add_f32 v[64:65], v[48:49], v[42:43]
    v_pk_add_f32 v[66:67], v[50:51], v[42:43]
    v_pk_add_f32 v[68:69], v[52:53], v[42:43]
    v_pk_add_f32 v[70:71], v[54:55], v[42:43]
    v_pk_add_f32 v[72:73], v[56:57], v[42:43]
    v_pk_add_f32 v[74:75], v[58:59], v[42:43]
    v_pk_add_f32 v[76:77], v[60:61], v[42:43]
    v_pk_add_f32 v[78:79], v[62:63], v[42:43]
    v_pk_mul_f32 v[42:43], v[64:65], v[64:65]
    v_pk_fma_f32 v[42:43], v[66:67], v[66:67], v[42:43]
    v_pk_fma_f32 v[42:43], v[68:69], v[68:69], v[42:43]
    v_pk_fma_f32 v[42:43], v[70:71], v[70:71], v[42:43]
    v_pk_fma_f32 v[42:43], v[72:73], v[72:73], v[42:43]
    v_pk_fma_f32 v[42:43], v[74:75], v[74:75], v[42:43]
    v_pk_fma_f32 v[42:43], v[76:77], v[76:77], v[42:43]
    v_pk_fma_f32 v[42:43], v[78:79], v[78:79], v[42:43]
    v_add_f32 v41, v42, v43
    v_mov_b32 v42, v41
    s_nop 1
    v_permlane16_swap_b32 v41, v42
    v_add_f32 v41, v41, v42
    s_nop 1
    v_add_f32_dpp v41, v41, v41 row_ror:1 row_mask:0xf bank_mask:0xf
    s_nop 1
    v_add_f32_dpp v41, v41, v41 row_ror:2 row_mask:0xf bank_mask:0xf
    s_nop 1
    v_add_f32_dpp v41, v41, v41 row_ror:4 row_mask:0xf bank_mask:0xf
    s_nop 1
    v_add_f32_dpp v41, v41, v41 row_ror:8 row_mask:0xf bank_mask:0xf
    v_mul_f32 v41, 0x3b000000, v41
    v_cvt_pk_bf16_f32 v42, v41, v40
    v_and_b32 v40, 0xffff0000, v42
    v_lshlrev_b32 v42, 16, v42
    v_add_f32 v42, 0x3727c5ac, v42
    v_cvt_pk_bf16_f32 v42, v42, v42
    v_lshlrev_b32 v42, 16, v42
    v_sqrt_f32 v43, v42
    v_rcp_f32 v44, v43
    v_fma_f32 v42, -v43, v43, v42
    v_mul_f32 v44, 0.5, v44
    v_fmac_f32 v43, v42, v44
    v_cvt_pk_bf16_f32 v43, v43, v43
    v_lshlrev_b32 v43, 16, v43
    v_rcp_f32 v44, v43
    s_nop 0
    v_fma_f32 v42, -v43, v44, 1.0
    v_fmac_f32 v44, v42, v44
    v_sub_f32 v40, 0, v40
    v_mov_b32 v41, v40
    v_mov_b32 v45, v44
    v_pk_add_f32 v[48:49], v[48:49], v[40:41]
    v_pk_add_f32 v[50:51], v[50:51], v[40:41]
    v_pk_add_f32 v[52:53], v[52:53], v[40:41]
    v_pk_add_f32 v[54:55], v[54:55], v[40:41]
    v_pk_add_f32 v[56:57], v[56:57], v[40:41]
    v_pk_add_f32 v[58:59], v[58:59], v[40:41]
    v_pk_add_f32 v[60:61], v[60:61], v[40:41]
    v_pk_add_f32 v[62:63], v[62:63], v[40:41]
    v_cvt_pk_bf16_f32 v24, v48, v49
    v_cvt_pk_bf16_f32 v25, v50, v51
    v_cvt_pk_bf16_f32 v26, v52, v53
    v_cvt_pk_bf16_f32 v27, v54, v55
    v_cvt_pk_bf16_f32 v28, v56, v57
    v_cvt_pk_bf16_f32 v29, v58, v59
    v_cvt_pk_bf16_f32 v30, v60, v61
    v_cvt_pk_bf16_f32 v31, v62, v63
    v_lshlrev_b32 v48, 16, v24
    v_and_b32 v49, 0xffff0000, v24
    v_lshlrev_b32 v50, 16, v25
    v_and_b32 v51, 0xffff0000, v25
    v_lshlrev_b32 v52, 16, v26
    v_and_b32 v53, 0xffff0000, v26
    v_lshlrev_b32 v54, 16, v27
    v_and_b32 v55, 0xffff0000, v27
    v_lshlrev_b32 v56, 16, v28
    v_and_b32 v57, 0xffff0000, v28
    v_lshlrev_b32 v58, 16, v29
    v_and_b32 v59, 0xffff0000, v29
    v_lshlrev_b32 v60, 16, v30
    v_and_b32 v61, 0xffff0000, v30
    v_lshlrev_b32 v62, 16, v31
    v_and_b32 v63, 0xffff0000, v31
    v_sub_f32 v42, 0, v43
    v_mov_b32 v43, v42
    v_pk_mul_f32 v[64:65], v[48:49], v[44:45]
    v_pk_mul_f32 v[66:67], v[50:51], v[44:45]
    v_pk_mul_f32 v[68:69], v[52:53], v[44:45]
    v_pk_mul_f32 v[70:71], v[54:55], v[44:45]
    v_pk_mul_f32 v[72:73], v[56:57], v[44:45]
    v_pk_mul_f32 v[74:75], v[58:59], v[44:45]
    v_pk_mul_f32 v[76:77], v[60:61], v[44:45]
    v_pk_mul_f32 v[78:79], v[62:63], v[44:45]
    v_pk_fma_f32 v[48:49], v[64:65], v[42:43], v[48:49]
    v_pk_fma_f32 v[50:51], v[66:67], v[42:43], v[50:51]
    v_pk_fma_f32 v[52:53], v[68:69], v[42:43], v[52:53]
    v_pk_fma_f32 v[54:55], v[70:71], v[42:43], v[54:55]
    v_pk_fma_f32 v[56:57], v[72:73], v[42:43], v[56:57]
    v_pk_fma_f32 v[58:59], v[74:75], v[42:43], v[58:59]
    v_pk_fma_f32 v[60:61], v[76:77], v[42:43], v[60:61]
    v_pk_fma_f32 v[62:63], v[78:79], v[42:43], v[62:63]
    v_pk_fma_f32 v[64:65], v[48:49], v[44:45], v[64:65]
    v_pk_fma_f32 v[66:67], v[50:51], v[44:45], v[66:67]
    v_pk_fma_f32 v[68:69], v[52:53], v[44:45], v[68:69]
    v_pk_fma_f32 v[70:71], v[54:55], v[44:45], v[70:71]
    v_pk_fma_f32 v[72:73], v[56:57], v[44:45], v[72:73]
    v_pk_fma_f32 v[74:75], v[58:59], v[44:45], v[74:75]
    v_pk_fma_f32 v[76:77], v[60:61], v[44:45], v[76:77]
    v_pk_fma_f32 v[78:79], v[62:63], v[44:45], v[78:79]
    v_cvt_pk_bf16_f32 v24, v64, v65
    v_cvt_pk_bf16_f32 v25, v66, v67
    v_cvt_pk_bf16_f32 v26, v68, v69
    v_cvt_pk_bf16_f32 v27, v70, v71
    v_cvt_pk_bf16_f32 v28, v72, v73
    v_cvt_pk_bf16_f32 v29, v74, v75
    v_cvt_pk_bf16_f32 v30, v76, v77
    v_cvt_pk_bf16_f32 v31, v78, v79
    ds_write_b128 v9, v[24:27] offset:4352
    ds_write_b128 v9, v[28:31] offset:4368
    s_waitcnt lgkmcnt(0)
    s_barrier
    s_add_u32 s60, s60, 1
    s_addc_u32 s61, s61, 0
    v_mov_b32 v26, s60
    v_mov_b32 v27, s61
    v_lshlrev_b32 v20, 16, v20
    v_lshlrev_b32 v21, 16, v21
    s_lshl_b32 s36, s30, 15
    s_lshl_b32 s37, s31, 9
    s_add_u32 s36, s36, s37
    s_add_u32 s36, s36, 262144
    v_lshrrev_b32 v12, 5, v1
    v_lshlrev_b32 v12, 14, v12
    v_and_b32 v6, 31, v1
    v_lshl_add_u32 v12, v6, 4, v12
    v_add_u32 v12, s36, v12
    v_lshlrev_b32 v15, 7, v6
    s_lshl_b32 s38, s30, 12
    s_add_u32 s38, s38, 32768
    v_add_u32 v15, s38, v15
    v_lshlrev_b32 v6, 3, v1
    s_lshl_b32 s38, s30, 15
    s_lshl_b32 s37, s32, 14
    s_add_u32 s38, s38, s37
    s_add_u32 s38, s38, 262144
    v_add_u32 v28, s38, v2
    v_add_u32 v29, 4096, v28
    v_add_u32 v30, 8192, v28
    v_add_u32 v31, 12288, v28
    v_lshlrev_b32 v16, 2, v1
    s_barrier
    ds_read_b64 v[32:33], v6 offset:6400
    ds_read_b64 v[34:35], v6 offset:6912
    ds_read_b64 v[36:37], v6 offset:7424
    ds_read_b64 v[38:39], v6 offset:7936
    ds_read_b64 v[40:41], v6 offset:8448
    ds_read_b64 v[42:43], v6 offset:8960
    ds_read_b64 v[44:45], v6 offset:9472
    ds_read_b64 v[46:47], v6 offset:9984
    s_cmp_eq_u32 s56, 0
    s_cbranch_scc1 L_noflag
    s_mov_b32 exec_lo, 0x01010101
    s_mov_b32 exec_hi, 0x01010101
    global_store_dwordx2 v19, v[26:27], s[28:29] sc1
    s_mov_b64 exec, -1
L_noflag:
    s_waitcnt lgkmcnt(0)
    v_pk_add_f32 v[32:33], v[32:33], v[34:35]
    v_pk_add_f32 v[36:37], v[36:37], v[38:39]
    v_pk_add_f32 v[40:41], v[40:41], v[42:43]
    v_pk_add_f32 v[44:45], v[44:45], v[46:47]
    v_pk_add_f32 v[32:33], v[32:33], v[36:37]
    v_pk_add_f32 v[40:41], v[40:41], v[44:45]
    v_pk_add_f32 v[24:25], v[32:33], v[40:41]
    global_store_dwordx4 v12, v[24:27], s[28:29] sc1
    s_barrier
    s_barrier
    s_barrier
    v_lshlrev_b32 v13, 5, v3
    s_barrier
    ds_read_b128 v[32:35], v13 offset:512
    ds_read_b128 v[36:39], v13 offset:528
    ds_read_b128 v[40:43], v13 offset:640
    ds_read_b128 v[44:47], v13 offset:656
    s_waitcnt lgkmcnt(0)
    v_max3_f32 v24, v32, v33, v34
    v_max3_f32 v25, v35, v36, v37
    v_max3_f32 v24, v24, v38, v39
    v_max_f32 v24, v24, v25
    v_min_u32 v24, -2, v24
    v_pk_add_f32 v[40:41], v[40:41], v[42:43]
    v_pk_add_f32 v[44:45], v[44:45], v[46:47]
    v_pk_add_f32 v[40:41], v[40:41], v[44:45]
    v_add_f32 v25, v40, v41
    v_min_u32 v25, -2, v25
    s_mov_b64 exec, 15
    v_add_u32 v6, 2097152, v17
    global_store_dwordx2 v6, v[24:25], s[28:29]
    global_store_dwordx2 v17, v[24:25], s[28:29] sc1
    s_mov_b64 exec, -1
    s_cmp_eq_u32 s55, 2
    s_cbranch_scc1 L_comm_end
L_poll_f:
    global_load_dwordx2 v[24:25], v15, s[28:29] sc1
    s_waitcnt vmcnt(0)
    v_cmp_ne_u64 vcc, s[60:61], v[24:25]
    s_nop 0
    s_cbranch_vccz L_poll_f_ok
    s_sub_u32 s62, s62, 1
    s_cmp_gt_i32 s62, 0
    s_cbranch_scc1 L_poll_f
L_poll_f_ok:
    s_cmp_eq_u32 s55, 1
    s_cbranch_scc1 L_comm_mlp
    s_barrier
    s_cmp_eq_u32 s56, 0
    s_cbranch_scc1 L_comm_end
    s_lshl_b32 s37, s57, 6
    v_lshlrev_b32 v19, 3, v7
    v_add_u32 v19, s37, v19
    v_lshl_add_u32 v14, v7, 2, v5
    v_lshlrev_b32 v14, 2, v14
    v_add_u32 v15, 24832, v14
    s_barrier
    ds_read2_b32 v[32:33], v15 offset0:0 offset1:32
    ds_read2_b32 v[34:35], v15 offset0:64 offset1:96
    ds_read2_b32 v[36:37], v15 offset0:128 offset1:160
    ds_read2_b32 v[38:39], v15 offset0:192 offset1:224
    s_waitcnt lgkmcnt(0)
    v_pk_add_f32 v[32:33], v[32:33], v[34:35]
    v_pk_add_f32 v[36:37], v[36:37], v[38:39]
    v_pk_add_f32 v[32:33], v[32:33], v[36:37]
    v_add_f32 v24, v32, v33
    v_cvt_pk_bf16_f32 v24, v24, v24
    v_lshlrev_b32 v24, 16, v24
    v_add_f32 v24, v24, v20
    v_cvt_pk_bf16_f32 v24, v24, v24
    v_lshlrev_b32 v22, 16, v24
    v_mov_b32 v24, v22
    v_mov_b32 v25, v22
    s_nop 1
    v_permlane16_swap_b32 v24, v25
    v_perm_b32 v24, v25, v24, s41
    v_mov_b32 v25, v24
    s_nop 1
    v_permlane32_swap_b32 v24, v25
    v_min_u32 v24, -2, v24
    v_min_u32 v25, -2, v25
    s_nop 0
    v_mov_b32_dpp v26, v24 quad_perm:[1,0,3,2] row_mask:0xf bank_mask:0xf
    v_mov_b32_dpp v27, v25 quad_perm:[1,0,3,2] row_mask:0xf bank_mask:0xf
    s_mov_b32 exec_lo, 0x55555555
    s_mov_b32 exec_hi, 0x55555555
    global_store_dwordx4 v18, v[24:27], s[28:29] sc1
    s_mov_b64 exec, -1
    s_cmp_lg_u32 s57, 0
    s_cbranch_scc1 L_noepoch
    v_mov_b32 v28, s60
    v_mov_b32 v29, s61
    s_mov_b64 exec, 1
    global_store_dwordx2 v11, v[28:29], s[28:29] sc1
    s_mov_b64 exec, -1
L_noepoch:
    s_barrier
    v_add_u32 v15, 25856, v14
    s_barrier
    ds_read2_b32 v[32:33], v15 offset0:0 offset1:32
    ds_read2_b32 v[34:35], v15 offset0:64 offset1:96
    ds_read2_b32 v[36:37], v15 offset0:128 offset1:160
    ds_read_b32 v38, v15 offset:768
    s_waitcnt lgkmcnt(0)
    v_pk_add_f32 v[32:33], v[32:33], v[34:35]
    v_add_f32 v36, v36, v38
    v_pk_add_f32 v[32:33], v[32:33], v[36:37]
    v_add_f32 v24, v32, v33
    v_cvt_pk_bf16_f32 v24, v24, v24
    v_lshlrev_b32 v24, 16, v24
    v_add_f32 v24, v24, v21
    v_cvt_pk_bf16_f32 v24, v24, v24
    v_lshlrev_b32 v24, 16, v24
    v_add_f32 v24, v24, v22
    v_cvt_pk_bf16_f32 v24, v24, v24
    v_lshlrev_b32 v23, 16, v24
    v_mov_b32 v24, v23
    v_mov_b32 v25, v23
    s_nop 1
    v_permlane16_swap_b32 v24, v25
    v_perm_b32 v24, v25, v24, s41
    v_mov_b32 v25, v24
    s_nop 1
    v_permlane32_swap_b32 v24, v25
    s_nop 1
    v_mov_b32_dpp v26, v24 quad_perm:[1,0,3,2] row_mask:0xf bank_mask:0xf
    v_mov_b32_dpp v27, v25 quad_perm:[1,0,3,2] row_mask:0xf bank_mask:0xf
    s_mov_b64 exec, 0x55
    global_store_dwordx4 v19, v[24:27], s[24:25]
    s_mov_b64 exec, -1
    s_branch L_comm_end
L_comm_mlp:
    v_lshrrev_b32 v12, 1, v1
    v_lshlrev_b32 v12, 7, v12
    v_and_b32 v14, 1, v1
    v_lshl_add_u32 v12, v14, 5, v12
    s_lshl_b32 s36, s30, 12
    s_add_u32 s36, s36, 196608
    v_add_u32 v12, s36, v12
    s_mov_b32 s36, 0x3f803f80
    s_nop 0
L_poll_h:
    global_load_dwordx4 v[24:27], v12, s[28:29] sc1
    global_load_dwordx4 v[28:31], v12, s[28:29] offset:16 sc1
    s_waitcnt vmcnt(0)
    v_max3_u32 v40, v24, v25, v26
    v_max3_u32 v40, v40, v27, v28
    v_max3_u32 v40, v40, v29, v30
    v_max_u32 v40, v40, v31
    v_cmp_eq_u32 vcc, -1, v40
    s_nop 0
    s_cbranch_vccz L_poll_h_ok
    s_sub_u32 s62, s62, 1
    s_cmp_gt_i32 s62, 0
    s_cbranch_scc1 L_poll_h
L_poll_h_ok:
    v_dot2_f32_bf16 v40, v24, s36, 0
    v_dot2_f32_bf16 v41, v24, v24, 0
    v_dot2_f32_bf16 v40, v25, s36, v40
    v_dot2_f32_bf16 v41, v25, v25, v41
    v_dot2_f32_bf16 v40, v26, s36, v40
    v_dot2_f32_bf16 v41, v26, v26, v41
    v_dot2_f32_bf16 v40, v27, s36, v40
    v_dot2_f32_bf16 v41, v27, v27, v41
    v_dot2_f32_bf16 v40, v28, s36, v40
    v_dot2_f32_bf16 v41, v28, v28, v41
    v_dot2_f32_bf16 v40, v29, s36, v40
    v_dot2_f32_bf16 v41, v29, v29, v41
    v_dot2_f32_bf16 v40, v30, s36, v40
    v_dot2_f32_bf16 v41, v30, v30, v41
    v_dot2_f32_bf16 v40, v31, s36, v40
    v_dot2_f32_bf16 v41, v31, v31, v41
    v_lshlrev_b32 v48, 16, v24
    v_and_b32 v49, 0xffff0000, v24
    v_lshlrev_b32 v50, 16, v25
    v_and_b32 v51, 0xffff0000, v25
    v_permlane16_swap_b32 v40, v41
    v_add_f32 v40, v40, v41
    v_lshlrev_b32 v52, 16, v26
    v_and_b32 v53, 0xffff0000, v26
    v_add_f32_dpp v40, v40, v40 row_ror:1 row_mask:0xf bank_mask:0xf
    v_lshlrev_b32 v54, 16, v27
    v_and_b32 v55, 0xffff0000, v27
    v_add_f32_dpp v40, v40, v40 row_ror:2 row_mask:0xf bank_mask:0xf
    v_lshlrev_b32 v56, 16, v28
    v_and_b32 v57, 0xffff0000, v28
    v_add_f32_dpp v40, v40, v40 row_ror:4 row_mask:0xf bank_mask:0xf
    v_lshlrev_b32 v58, 16, v29
    v_and_b32 v59, 0xffff0000, v29
    v_add_f32_dpp v40, v40, v40 row_ror:8 row_mask:0xf bank_mask:0xf
    v_mov_b32 v41, v40
    v_lshlrev_b32 v60, 16, v30
    v_and_b32 v61, 0xffff0000, v30
    v_lshlrev_b32 v62, 16, v31
    v_and_b32 v63, 0xffff0000, v31
    v_permlane16_swap_b32 v40, v41
    v_mul_f32 v40, 0x3b000000, v40
    v_mul_f32 v41, 0x3b000000, v41
    v_fma_f32 v41, -v40, v40, v41
    v_max_f32 v41, 0, v41
    v_cvt_pk_bf16_f32 v42, v41, v40
    v_and_b32 v40, 0xffff0000, v42
    v_lshlrev_b32 v42, 16, v42
    v_add_f32 v42, 0x3727c5ac, v42
    v_cvt_pk_bf16_f32 v42, v42, v42
    v_lshlrev_b32 v42, 16, v42
    v_sqrt_f32 v43, v42
    v_rcp_f32 v44, v43
    v_fma_f32 v42, -v43, v43, v42
    v_mul_f32 v44, 0.5, v44
    v_fmac_f32 v43, v42, v44
    v_cvt_pk_bf16_f32 v43, v43, v43
    v_lshlrev_b32 v43, 16, v43
    v_rcp_f32 v44, v43
    s_nop 0
    v_fma_f32 v42, -v43, v44, 1.0
    v_fmac_f32 v44, v42, v44
    v_sub_f32 v40, 0, v40
    v_mov_b32 v41, v40
    v_mov_b32 v45, v44
    v_pk_add_f32 v[48:49], v[48:49], v[40:41]
    v_pk_add_f32 v[50:51], v[50:51], v[40:41]
    v_pk_add_f32 v[52:53], v[52:53], v[40:41]
    v_pk_add_f32 v[54:55], v[54:55], v[40:41]
    v_pk_add_f32 v[56:57], v[56:57], v[40:41]
    v_pk_add_f32 v[58:59], v[58:59], v[40:41]
    v_pk_add_f32 v[60:61], v[60:61], v[40:41]
    v_pk_add_f32 v[62:63], v[62:63], v[40:41]
    v_cvt_pk_bf16_f32 v24, v48, v49
    v_cvt_pk_bf16_f32 v25, v50, v51
    v_cvt_pk_bf16_f32 v26, v52, v53
    v_cvt_pk_bf16_f32 v27, v54, v55
    v_cvt_pk_bf16_f32 v28, v56, v57
    v_cvt_pk_bf16_f32 v29, v58, v59
    v_cvt_pk_bf16_f32 v30, v60, v61
    v_cvt_pk_bf16_f32 v31, v62, v63
    v_lshlrev_b32 v48, 16, v24
    v_and_b32 v49, 0xffff0000, v24
    v_lshlrev_b32 v50, 16, v25
    v_and_b32 v51, 0xffff0000, v25
    v_lshlrev_b32 v52, 16, v26
    v_and_b32 v53, 0xffff0000, v26
    v_lshlrev_b32 v54, 16, v27
    v_and_b32 v55, 0xffff0000, v27
    v_lshlrev_b32 v56, 16, v28
    v_and_b32 v57, 0xffff0000, v28
    v_lshlrev_b32 v58, 16, v29
    v_and_b32 v59, 0xffff0000, v29
    v_lshlrev_b32 v60, 16, v30
    v_and_b32 v61, 0xffff0000, v30
    v_lshlrev_b32 v62, 16, v31
    v_and_b32 v63, 0xffff0000, v31
    v_pk_mul_f32 v[48:49], v[48:49], v[44:45]
    v_pk_mul_f32 v[50:51], v[50:51], v[44:45]
    v_pk_mul_f32 v[52:53], v[52:53], v[44:45]
    v_pk_mul_f32 v[54:55], v[54:55], v[44:45]
    v_pk_mul_f32 v[56:57], v[56:57], v[44:45]
    v_pk_mul_f32 v[58:59], v[58:59], v[44:45]
    v_pk_mul_f32 v[60:61], v[60:61], v[44:45]
    v_pk_mul_f32 v[62:63], v[62:63], v[44:45]
    v_cvt_pk_bf16_f32 v24, v48, v49
    v_cvt_pk_bf16_f32 v25, v50, v51
    v_cvt_pk_bf16_f32 v26, v52, v53
    v_cvt_pk_bf16_f32 v27, v54, v55
    v_cvt_pk_bf16_f32 v28, v56, v57
    v_cvt_pk_bf16_f32 v29, v58, v59
    v_cvt_pk_bf16_f32 v30, v60, v61
    v_cvt_pk_bf16_f32 v31, v62, v63
    ds_write_b128 v9, v[24:27] offset:4352
    ds_write_b128 v9, v[28:31] offset:4368
    s_waitcnt lgkmcnt(0)
    s_barrier
L_comm_end:
L_end:
    s_endpgm
.section .rodata,"a"
.p2align 6
.amdhsa_kernel sequential_preLN__sliding_block_cached__dense_activation_gelu__decode_kernel
  .amdhsa_next_free_vgpr 168
  .amdhsa_next_free_sgpr 102
  .amdhsa_accum_offset 168
  .amdhsa_group_segment_fixed_size 0
  .amdhsa_kernarg_size 104
  .amdhsa_user_sgpr_count 2
  .amdhsa_user_sgpr_kernarg_segment_ptr 1
  .amdhsa_system_sgpr_workgroup_id_x 1
  .amdhsa_float_denorm_mode_32 3
.end_amdhsa_kernel
```
